```python
import torch

def _softmax(x, axis=-1):
    return torch.softmax(x, dim=axis)
def _gelu(x):
    return torch.nn.functional.gelu(x, approximate="tanh")
def _silu(x):
    return torch.nn.functional.silu(x)
def _sigmoid(x):
    return torch.sigmoid(x)
def _layernorm(x, axis=-1, eps=1e-5):
    m = x.mean(dim=axis, keepdim=True)
    v = x.var(dim=axis, keepdim=True, unbiased=False)
    return (x - m) / torch.sqrt(v + eps)
def _scatter_add(tgt, idx, src, axis=0):
    return tgt.clone().index_add_(axis, idx, src)
def _segment_sum(src, seg, n):
    out = torch.zeros((n,) + src.shape[1:], dtype=src.dtype)
    return out.index_add_(0, seg, src)
def _pad(x, pw):
    flat = tuple(v for pair in reversed(pw) for v in pair)
    return torch.nn.functional.pad(x, flat)

kernel_name = 'sequential_preLN__sliding_block_cached__swiglu_ffn__decode'

def setup_inputs():

    _w = (lambda a: (lambda t: t.to(torch.bfloat16) if t.is_floating_point() else t)(torch.as_tensor(a)))
    def _A_setup():
        B, Sq, D = 1, 1, 512
        Hq, Hkv, Sk, Dh = 32, 8, 65536, 128
        assert Hq % Hkv == 0, (Hq, Hkv)
        return {
            "x": _w((lambda *s: torch.randn(*s, dtype=torch.bfloat16) * 0.05)(B, Sq, D)),
            "k_cache": _w((lambda *s: torch.randn(*s, dtype=torch.bfloat16) * 3.2)(B, Hkv, Sk, Dh)),
            "v_cache": _w((lambda *s: torch.randn(*s, dtype=torch.bfloat16) * 0.4)(B, Hkv, Sk, Dh)),
            "wq": _w((lambda *s: torch.randn(*s, dtype=torch.bfloat16) * 3.2)(D, Hq * Dh) * (D ** -0.5)),
            "wo": _w((lambda *s: torch.randn(*s, dtype=torch.bfloat16) * 0.4)(Hq * Dh, D) * ((Hq * Dh) ** -0.5)),
        }
    _A_in = _A_setup()

    def _B_setup():
        B, S, D, F = 1, 1, 512, 1792
        return {
            "x": _w((lambda *s: torch.randn(*s, dtype=torch.bfloat16) * 0.05)(B, S, D)),
            "w_gate": _w((lambda *s: torch.randn(*s, dtype=torch.bfloat16) * 0.05)(D, F)),
            "w_up": _w((lambda *s: torch.randn(*s, dtype=torch.bfloat16) * 0.05)(D, F)),
            "w_down": _w((lambda *s: torch.randn(*s, dtype=torch.bfloat16) * 0.05)(F, D)),
        }
    _B_in = _B_setup()

    return {
        "A_x": _A_in["x"],
        "A_k_cache": _A_in["k_cache"],
        "A_v_cache": _A_in["v_cache"],
        "A_wq": _A_in["wq"],
        "A_wo": _A_in["wo"],
        "B_x": _B_in["x"],
        "B_w_gate": _B_in["w_gate"],
        "B_w_up": _B_in["w_up"],
        "B_w_down": _B_in["w_down"],
    }

def reference(A_x, A_k_cache, A_v_cache, A_wq, A_wo, B_x, B_w_gate, B_w_up, B_w_down):
    def _A_ref(x, k_cache, v_cache, wq, wo):
        B, Sq, D = x.shape
        Hq, Dh = 32, 128
        Hkv, Sk = k_cache.shape[1], k_cache.shape[2]
        W = min(4096, max(256, Sk // 4))
        rep = Hq // Hkv
        q = (lambda x, *d: x.permute(*d))((x @ wq).reshape(B, Sq, Hq, Dh), 0, 2, 1, 3)
        k = (lambda x, n, axis: torch.repeat_interleave(x, n, dim=axis))(k_cache[:, :, Sk - W:, :], rep, axis=1)
        v = (lambda x, n, axis: torch.repeat_interleave(x, n, dim=axis))(v_cache[:, :, Sk - W:, :], rep, axis=1)
        scores = torch.einsum("bhqd,bhkd->bhqk", q, k) * (Dh ** -0.5)
        p = _softmax(scores, axis=-1)
        o = torch.einsum("bhqk,bhkd->bhqd", p, v)
        return (lambda x, *d: x.permute(*d))(o, 0, 2, 1, 3).reshape(B, Sq, Hq * Dh) @ wo

    def _B_ref(x, w_gate, w_up, w_down):
        g = _silu(x @ w_gate)
        u = x @ w_up
        return (g * u) @ w_down

    x = A_x
    h = x + _A_ref(_layernorm(x, axis=-1), A_k_cache, A_v_cache, A_wq, A_wo)
    h2 = h + _B_ref(_layernorm(h, axis=-1), B_w_gate, B_w_up, B_w_down)
    return h2
```

```asm
; @launch grid=(256,1,1) block=(512,1,1) lds=136320
.amdgcn_target "amdgcn-amd-amdhsa--gfx950"
.text
.globl sequential_preLN__sliding_block_cached__swiglu_ffn__decode_kernel
.p2align 12
.type sequential_preLN__sliding_block_cached__swiglu_ffn__decode_kernel,@function
sequential_preLN__sliding_block_cached__swiglu_ffn__decode_kernel:
    s_cmp_ge_u32 s2, 256
    s_cbranch_scc1 L_end
    s_load_dwordx16 s[4:19], s[0:1], 0
    s_load_dwordx8 s[20:27], s[0:1], 64
    s_lshr_b32 s30, s2, 3
    s_xor_b32 s30, s30, 16
    s_getpc_b64 s[50:51]
L_pc:
    v_lshl_add_u32 v6, v0, 5, s30
    v_lshlrev_b32 v6, 7, v6
    v_cmp_gt_u32 vcc, L_code_end-L_pc-4, v6
    s_and_saveexec_b64 s[44:45], vcc
    s_cbranch_execz L_nopf
    global_load_dword v95, v6, s[50:51]
L_nopf:
    s_mov_b64 exec, -1
    v_lshrrev_b32 v6, 6, v0
    v_and_b32 v1, 63, v0
    s_and_b32 s29, s2, 7
    v_readfirstlane_b32 s28, v6
    v_and_b32 v2, 15, v0
    v_lshrrev_b32 v3, 4, v1
    v_lshrrev_b32 v7, 3, v1
    v_lshlrev_b32 v16, 4, v1
    v_and_b32 v10, 7, v0
    v_and_b32 v11, 1, v3
    v_lshlrev_b32 v11, 1, v11
    v_xor_b32 v10, v10, v11
    v_lshlrev_b32 v10, 4, v10
    s_cmp_ge_u32 s30, 16
    s_cbranch_scc1 L_attn
    s_and_b32 s56, s30, 7
    s_lshr_b32 s57, s30, 3
    s_lshl_b32 s44, s29, 10
    s_lshl_b32 s45, s56, 7
    s_add_u32 s44, s44, s45
    s_lshl_b32 s45, s57, 21
    s_add_u32 s44, s44, s45
    s_lshl_b32 s45, s28, 18
    s_add_u32 s44, s44, s45
    v_lshl_add_u32 v12, v7, 13, v10
    v_add_u32 v12, s44, v12
    v_xor_b32 v13, 64, v12
    v_add_u32 v13, 64512, v13
    v_add_u32 v14, 129024, v12
    v_add_u32 v15, 129024, v13
    s_lshl_b32 s49, s28, 12
    s_mov_b32 m0, s49
    s_cmp_lg_u32 s28, 0
    s_waitcnt lgkmcnt(0)
    s_cbranch_scc1 L_nox
    global_load_dwordx4 v[20:23], v16, s[4:5]
L_nox:
    global_load_lds_dwordx4 v12, s[10:11] offset:0 nt
    global_load_lds_dwordx4 v13, s[10:11] offset:1024 nt
    s_load_dword s31, s[26:27], 0
    s_lshl_b32 s54, s29, 13
    s_lshl_b32 s45, s56, 10
    s_add_u32 s54, s54, s45
    s_lshl_b32 s45, s57, 9
    s_add_u32 s54, s54, s45
    s_add_u32 s54, s54, 65536
    s_and_b32 s45, s28, 3
    s_lshl_b32 s45, s45, 7
    s_add_u32 s45, s45, s54
    s_load_dword s52, s[26:27], s45
    s_and_b32 s44, s30, 3
    s_lshl_b32 s44, s44, 7
    s_lshl_b32 s45, s29, 9
    s_add_u32 s44, s44, s45
    s_add_u32 s44, s44, 16384
    s_load_dword s52, s[26:27], s44
    s_branch L_service
L_attn:
    s_sub_u32 s39, s30, 16
    s_lshl_b32 s48, s29, 24
    s_lshl_b32 s45, s39, 14
    s_add_u32 s48, s48, s45
    s_lshl_b32 s45, s28, 10
    s_add_u32 s48, s48, s45
    s_add_u32 s48, s48, 15728640
    s_lshl_b32 s52, s28, 10
    s_mov_b32 m0, s52
    s_and_b32 s53, s28, 3
    s_lshl_b32 s44, s53, 6
    v_xor_b32 v12, v2, v3
    v_lshlrev_b32 v17, 4, v12
    v_xor_b32 v12, s44, v17
    v_lshl_add_u32 v12, v3, 8, v12
    v_add_u32 v12, s48, v12
    s_waitcnt lgkmcnt(0)
    global_load_lds_dwordx4 v12, s[6:7] nt
    s_barrier
    s_add_u32 s52, s52, 8192
    s_mov_b32 m0, s52
    v_add_u32 v12, 8192, v12
    global_load_lds_dwordx4 v12, s[6:7] nt
    s_load_dword s31, s[26:27], 0
    s_getreg_b32 s36, hwreg(HW_REG_XCC_ID, 0, 4)
    v_mov_b32 v4, 0xffffff00
    v_mov_b32 v5, 0
    s_mov_b32 s40, 0x00010001
    s_mov_b32 s41, 0x00010001
    s_mov_b32 s42, 0x000f000f
    s_mov_b32 s43, 0x000f000f
    s_mov_b32 s38, 1048576
    s_mov_b32 s37, 0
    v_bfe_u32 v18, v0, 2, 2
    v_and_b32 v9, 3, v0
    v_lshlrev_b32 v19, 3, v9
    v_lshl_add_u32 v8, v3, 3, v18
    v_lshlrev_b32 v24, 7, v8
    v_add_u32 v24, v24, v19
    v_lshrrev_b32 v25, 1, v18
    v_or_b32 v25, v25, v11
    v_lshl_or_b32 v24, v25, 5, v24
    v_and_b32 v27, 31, v0
    v_lshlrev_b32 v27, 2, v27
    v_add_u32 v27, 135808, v27
    ds_write_b32 v27, v5
    v_cmp_eq_u32 s[14:15], 0, v2
    v_cmp_eq_u32 s[24:25], 1, v2
    v_cmp_eq_u32 s[0:1], 2, v2
    v_cmp_eq_u32 s[46:47], 3, v2
    s_and_b32 s49, s28, 1
    s_lshl_b32 s45, s49, 2
    v_or_b32 v96, s45, v3
    v_lshlrev_b32 v96, 1, v96
    v_xor_b32 v96, v96, v2
    v_lshlrev_b32 v96, 4, v96
    v_lshl_add_u32 v96, v3, 8, v96
    v_add_u32 v96, s48, v96
    s_lshl_b32 s3, s28, 10
    s_add_u32 s3, s3, 65536
    v_lshl_add_u32 v8, v3, 2, v18
    v_and_b32 v97, 7, v8
    v_xor_b32 v97, s28, v97
    v_lshlrev_b32 v97, 5, v97
    v_lshl_add_u32 v97, v8, 8, v97
    v_add_u32 v97, v97, v19
    v_add_u32 v97, 65536, v97
    s_lshl_b32 s44, s28, 13
    v_lshl_add_u32 v98, v2, 8, v17
    v_add_u32 v98, s44, v98
    v_xor_b32 v99, 64, v98
    v_xor_b32 v100, 0x80, v98
    v_xor_b32 v101, 0xc0, v98
    v_mul_u32_u24 v25, 320, v9
    v_lshl_add_u32 v102, v3, 4, v25
    v_add_u32 v102, 132096, v102
    s_lshr_b32 s48, s28, 1
    v_lshrrev_b32 v25, 5, v1
    v_lshlrev_b32 v25, 8, v25
    v_lshl_add_u32 v25, v9, 6, v25
    v_lshl_add_u32 v25, v11, 3, v25
    v_add_u32 v25, 133376, v25
    v_bfe_u32 v103, v0, 3, 1
    v_lshl_add_u32 v103, v103, 5, v25
    s_lshl_b32 s44, s48, 9
    s_lshl_b32 s45, s49, 5
    s_add_u32 s44, s44, s45
    v_lshl_add_u32 v106, v18, 2, v25
    v_add_u32 v106, s44, v106
    v_lshlrev_b32 v105, 2, v9
    v_add_u32 v105, 131584, v105
    v_mov_b32 v25, 0xff800000
    ds_write_b32 v105, v25
    v_lshlrev_b32 v104, 7, v9
    v_lshl_add_u32 v104, v3, 2, v104
    s_lshl_b32 s44, s28, 4
    s_add_u32 s44, s44, 131072
    v_add_u32 v104, s44, v104
    v_lshlrev_b32 v113, 7, v9
    v_lshl_add_u32 v113, v18, 5, v113
    v_add_u32 v113, 131072, v113
    s_lshl_b32 s44, s29, 15
    s_lshl_b32 s45, s48, 11
    s_add_u32 s44, s44, s45
    s_waitcnt vmcnt(1)
    s_add_u32 s52, s52, 8192
    s_mov_b32 m0, s52
    v_add_u32 v12, 253952, v12
    global_load_lds_dwordx4 v12, s[6:7] nt
    s_lshl_b32 s45, s39, 7
    s_add_u32 s44, s44, s45
    s_lshl_b32 s45, s49, 6
    s_add_u32 s44, s44, s45
    s_add_u32 s44, s44, 786432
    v_lshlrev_b32 v107, 13, v9
    v_lshl_add_u32 v107, v3, 4, v107
    v_add_u32 v107, s44, v107
    s_lshl_b32 s44, s29, 10
    s_lshl_b32 s45, s39, 4
    s_add_u32 s44, s44, s45
    s_add_u32 s44, s44, 8192
    v_lshl_add_u32 v108, v9, 8, s44
    s_mul_i32 s44, s48, 320
    s_lshl_b32 s45, s49, 7
    s_add_u32 s44, s44, s45
    s_add_u32 s44, s44, 132096
    v_lshl_add_u32 v109, v1, 2, s44
    s_lshl_b32 s44, s29, 13
    s_lshl_b32 s45, s28, 10
    s_add_u32 s44, s44, s45
    s_add_u32 s44, s44, 65536
    v_add_u32 v110, s44, v16
    s_lshl_b32 s44, s29, 9
    s_lshl_b32 s45, s39, 2
    s_add_u32 s44, s44, s45
    s_add_u32 s44, s44, 16384
    v_mov_b32 v111, s44
    s_lshl_b32 s44, s29, 9
    s_add_u32 s44, s44, 16384
    v_lshl_add_u32 v114, v2, 2, s44
    s_lshl_b32 s44, s28, 2
    s_add_u32 s44, s44, 135680
    v_mov_b32 v112, s44
    s_mov_b32 s56, 0xf0f0f0f0
    s_mov_b32 s57, 0xf0f0f0f0
    s_mov_b32 s58, 0xff00ff00
    s_mov_b32 s59, 0xff00ff00
    s_lshr_b32 s48, s39, 2
    s_lshl_b32 s30, s48, 3
    s_barrier
    s_add_u32 s52, s52, 8192
    s_mov_b32 m0, s52
    v_add_u32 v12, 8192, v12
    global_load_lds_dwordx4 v12, s[6:7] nt
    s_and_b32 s48, s29, 1
    s_xor_b32 s48, s48, 1
    s_lshl_b32 s48, s48, 2
    s_lshr_b32 s45, s29, 1
    s_or_b32 s48, s48, s45
    s_add_u32 s30, s30, s48
    s_and_b32 s48, s39, 3
    s_lshl_b32 s39, s30, 2
    s_add_u32 s39, s39, s53
    s_lshr_b32 s49, s28, 2
    s_mul_i32 s44, s48, 458752
    s_mul_i32 s45, s28, 57344
    s_add_u32 s44, s44, s45
    s_lshl_b32 s45, s30, 7
    s_add_u32 s44, s44, s45
    v_mul_u32_u24 v116, 3584, v7
    v_add_u32 v116, v116, v10
    v_add_u32 v116, s44, v116
    v_xor_b32 v117, 64, v116
    v_add_u32 v117, 27648, v117
    s_lshl_b32 s44, s53, 5
    v_xor_b32 v118, s44, v24
    s_lshl_b32 s44, s49, 13
    v_add_u32 v118, s44, v118
    v_and_b32 v26, 7, v0
    s_lshl_b32 s44, s48, 9
    s_lshl_b32 s45, s28, 6
    s_add_u32 s44, s44, s45
    s_lshl_b32 s45, s29, 14
    s_add_u32 s44, s44, s45
    s_add_u32 s44, s44, 1310720
    v_lshlrev_b32 v119, 11, v7
    v_lshl_add_u32 v119, v26, 3, v119
    v_add_u32 v119, s44, v119
    v_lshrrev_b32 v25, 5, v1
    v_lshl_add_u32 v25, v26, 1, v25
    v_lshlrev_b32 v25, 1, v25
    s_lshl_b32 s44, s28, 5
    s_add_u32 s44, s44, 136064
    v_add_u32 v120, s44, v25
    s_barrier
    s_waitcnt vmcnt(3)
    s_add_u32 s52, s52, 8192
    s_mov_b32 m0, s52
    v_add_u32 v12, 253952, v12
    global_load_lds_dwordx4 v12, s[6:7] nt
    s_lshl_b32 s44, s48, 8
    s_lshl_b32 s45, s28, 5
    s_add_u32 s44, s44, s45
    v_add_u32 v123, s44, v25
    v_cmp_eq_u32 vcc, 1, v2
    s_lshl_b32 s44, s49, 7
    s_add_u32 s44, s44, 136064
    v_lshl_add_u32 v121, v3, 4, s44
    v_mov_b32 v25, 135936
    v_cndmask_b32 v121, v121, v25, vcc
    s_lshl_b32 s44, s39, 11
    s_lshl_b32 s45, s48, 9
    s_add_u32 s44, s44, s45
    s_lshl_b32 s45, s49, 8
    s_add_u32 s44, s44, s45
    s_add_u32 s44, s44, 1048576
    v_lshl_add_u32 v122, v2, 4, s44
    s_lshl_b32 s44, s39, 7
    s_lshl_b32 s45, s48, 5
    s_add_u32 s44, s44, s45
    s_lshl_b32 s45, s49, 4
    s_add_u32 s44, s44, s45
    s_add_u32 s44, s44, 196608
    v_writelane_b32 v122, s44, 16
    s_lshl_b32 s44, s49, 7
    s_add_u32 s44, s44, 136064
    v_lshl_add_u32 v126, v1, 1, s44
    v_and_b32 v22, 31, v0
    v_lshlrev_b32 v22, 2, v22
    v_add_u32 v22, 135936, v22
    v_mov_b32 v25, 0x3f803f80
    ds_write_b32 v22, v25
    s_waitcnt vmcnt(3)
    s_add_u32 s52, s52, 8192
    s_mov_b32 m0, s52
    v_add_u32 v12, 8192, v12
    global_load_lds_dwordx4 v12, s[6:7] nt
    s_waitcnt vmcnt(3)
    s_add_u32 s52, s52, 8192
    s_mov_b32 m0, s52
    v_add_u32 v12, 253952, v12
    global_load_lds_dwordx4 v12, s[6:7] nt
    s_waitcnt vmcnt(3)
    s_add_u32 s52, s52, 8192
    s_mov_b32 m0, s52
    v_add_u32 v12, 8192, v12
    global_load_lds_dwordx4 v12, s[6:7] nt
    s_waitcnt lgkmcnt(0)
    s_add_u32 s31, s31, 2654435769
    s_and_b32 s32, s31, 0xff
    s_bfe_u32 s33, s31, 0x80008
    s_bfe_u32 s34, s31, 0x80010
    s_lshr_b32 s35, s31, 24
    v_mov_b32 v69, s31
    v_and_b32 v25, 1, v0
    v_lshlrev_b32 v25, 4, v25
    v_lshrrev_b32 v124, v25, s31
    v_bfe_u32 v125, v124, 8, 8
    v_and_b32 v124, 0xff, v124
    s_waitcnt vmcnt(3)
    s_mov_b32 m0, s3
    s_add_u32 s3, s3, 8192
    global_load_lds_dwordx4 v96, s[8:9] nt
    v_add_u32 v96, 8192, v96
    s_waitcnt vmcnt(3)
    s_mov_b32 m0, s3
    s_add_u32 s3, s3, 8192
    global_load_lds_dwordx4 v96, s[8:9] nt
    v_add_u32 v96, 253952, v96
    s_waitcnt vmcnt(3)
    s_mov_b32 m0, s3
    s_add_u32 s3, s3, 8192
    global_load_lds_dwordx4 v96, s[8:9] nt
    v_add_u32 v96, 8192, v96
    s_waitcnt vmcnt(3)
    s_mov_b32 m0, s3
    s_add_u32 s3, s3, 8192
    global_load_lds_dwordx4 v96, s[8:9] nt
    v_add_u32 v96, 253952, v96
    global_load_dwordx4 v[128:131], v110, s[26:27] sc1
    s_barrier
    ds_read_b128 v[28:31], v98 offset:0
    ds_read_b128 v[32:35], v99 offset:0
    ds_read_b128 v[36:39], v100 offset:0
    ds_read_b128 v[40:43], v101 offset:0
    ds_read_b128 v[44:47], v98 offset:4096
    ds_read_b128 v[48:51], v99 offset:4096
    ds_read_b128 v[52:55], v100 offset:4096
    ds_read_b128 v[56:59], v101 offset:4096
    s_waitcnt vmcnt(4)
    s_mov_b32 m0, s3
    s_add_u32 s3, s3, 8192
    global_load_lds_dwordx4 v96, s[8:9] nt
    v_add_u32 v96, 8192, v96
    s_cmp_lg_u32 s28, 0
    s_cbranch_scc1 L_noflag
    s_mov_b64 exec, 1
    global_store_dword v111, v69, s[26:27]
    s_mov_b64 exec, -1
L_noflag:
    s_waitcnt vmcnt(4)
    s_mov_b32 m0, s3
    s_add_u32 s3, s3, 8192
    global_load_lds_dwordx4 v96, s[8:9] nt
    v_add_u32 v96, 253952, v96
    s_waitcnt vmcnt(4)
    s_mov_b32 m0, s3
    s_add_u32 s3, s3, 8192
    global_load_lds_dwordx4 v96, s[8:9] nt
    v_add_u32 v96, 8192, v96
    s_waitcnt vmcnt(4)
    s_mov_b32 m0, s3
    s_add_u32 s3, s3, 8192
    global_load_lds_dwordx4 v96, s[8:9] nt
    s_waitcnt vmcnt(4)
    v_cmp_ne_u32 vcc, s31, v130
    s_cbranch_vccnz L_q_late
L_qok:
    v_cmp_ne_u32 vcc, s36, v131
    v_mov_b32 v20, v128
    v_mov_b32 v21, v129
    s_nop 0
    v_permlane32_swap_b32 v128, v20
    v_permlane32_swap_b32 v129, v21
    v_add_f32 v20, v128, v20
    v_add_f32 v21, v129, v21
    v_cvt_pk_bf16_f32 v20, v20, v21
    s_cmp_lg_u64 vcc, 0
    s_cselect_b32 s44, 1, 0
    v_mov_b32 v21, s44
    s_mov_b64 exec, 0xffffffff
    ds_write_b32 v109, v20
    s_mov_b64 exec, 1
    ds_write_b32 v112, v21
    s_mov_b64 exec, -1
    v_mov_b32 v20, 135680
    s_waitcnt lgkmcnt(0)
    s_barrier
    ds_read_b128 v[72:75], v102 offset:0
    ds_read_b128 v[76:79], v102 offset:64
    ds_read_b128 v[80:83], v102 offset:128
    ds_read_b128 v[84:87], v102 offset:192
    ds_read_b128 v[88:91], v20 offset:16
    ds_read_b128 v[20:23], v20
    ds_read_b64_tr_b16 v[140:141], v97 offset:0
    ds_read_b64_tr_b16 v[142:143], v97 offset:4096
    ds_read_b64_tr_b16 v[144:145], v97 offset:8192
    ds_read_b64_tr_b16 v[146:147], v97 offset:12288
    ds_read_b64_tr_b16 v[148:149], v97 offset:16384
    ds_read_b64_tr_b16 v[150:151], v97 offset:20480
    ds_read_b64_tr_b16 v[152:153], v97 offset:24576
    ds_read_b64_tr_b16 v[154:155], v97 offset:28672
    s_waitcnt lgkmcnt(13)
    v_mfma_f32_16x16x32_bf16 v[60:63], v[28:31], v[72:75], 0
    v_mfma_f32_16x16x32_bf16 v[64:67], v[44:47], v[72:75], 0
    s_waitcnt lgkmcnt(12)
    v_mfma_f32_16x16x32_bf16 v[60:63], v[32:35], v[76:79], v[60:63]
    v_mfma_f32_16x16x32_bf16 v[64:67], v[48:51], v[76:79], v[64:67]
    s_waitcnt lgkmcnt(11)
    v_mfma_f32_16x16x32_bf16 v[60:63], v[36:39], v[80:83], v[60:63]
    v_mfma_f32_16x16x32_bf16 v[64:67], v[52:55], v[80:83], v[64:67]
    s_waitcnt lgkmcnt(10)
    v_mfma_f32_16x16x32_bf16 v[60:63], v[40:43], v[84:87], v[60:63]
    v_mfma_f32_16x16x32_bf16 v[64:67], v[56:59], v[84:87], v[64:67]
    s_waitcnt lgkmcnt(8)
    v_or3_b32 v20, v20, v21, v22
    v_or3_b32 v20, v20, v23, v88
    v_or3_b32 v20, v20, v89, v90
    v_or_b32 v20, v20, v91
    s_nop 0
    v_readfirstlane_b32 s37, v20
    v_cndmask_b32 v28, v60, v62, s[56:57]
    v_cndmask_b32 v29, v61, v63, s[56:57]
    v_cndmask_b32 v30, v64, v66, s[56:57]
    v_cndmask_b32 v31, v65, v67, s[56:57]
    v_cndmask_b32 v28, v28, v30, s[58:59]
    v_cndmask_b32 v29, v29, v31, s[58:59]
    v_cvt_pk_bf16_f32 v28, v28, v29
    v_and_b32 v29, 0xffff0000, v28
    v_lshlrev_b32 v28, 16, v28
    v_mul_f32 v29, 0x3db504f3, v29
    v_mul_f32 v28, 0x3db504f3, v28
    v_cvt_pk_bf16_f32 v28, v28, v29
    v_and_b32 v29, 0xffff0000, v28
    v_lshlrev_b32 v28, 16, v28
    v_max_f32 v20, v28, v29
    s_nop 1
    v_max_f32_dpp v20, v20, v20 row_ror:4 row_mask:0xf bank_mask:0xf
    s_nop 1
    v_max_f32_dpp v20, v20, v20 row_ror:8 row_mask:0xf bank_mask:0xf
    s_mov_b64 exec, s[42:43]
    ds_max_f32 v105, v20
    s_mov_b64 exec, -1
    s_waitcnt vmcnt(4) lgkmcnt(0)
    s_barrier
    ds_read_b32 v20, v105
    s_waitcnt lgkmcnt(0)
    v_sub_f32 v28, v28, v20
    v_sub_f32 v29, v29, v20
    v_mul_f32 v28, 0x3fb8aa3b, v28
    v_mul_f32 v29, 0x3fb8aa3b, v29
    v_exp_f32 v28, v28
    v_exp_f32 v29, v29
    s_nop 0
    v_cvt_pk_bf16_f32 v30, v28, v29
    ds_write_b32 v106, v30
    v_add_f32 v21, v28, v29
    s_nop 1
    v_add_f32_dpp v21, v21, v21 row_ror:4 row_mask:0xf bank_mask:0xf
    s_nop 1
    v_add_f32_dpp v21, v21, v21 row_ror:8 row_mask:0xf bank_mask:0xf
    s_mov_b64 exec, s[42:43]
    ds_write_b32 v104, v21
    s_mov_b64 exec, -1
    s_waitcnt vmcnt(2) lgkmcnt(0)
    s_barrier
    s_cmp_lg_u32 s28, 7
    s_cbranch_scc1 L_pv
    ds_read_b128 v[12:15], v113
    ds_read_b128 v[72:75], v113 offset:16
    v_mov_b32 v22, s31
    v_mov_b32 v23, s31
    ds_read_b128 v[28:31], v103 offset:0
    ds_read_b128 v[32:35], v103 offset:512
    ds_read_b128 v[36:39], v103 offset:1024
    ds_read_b128 v[40:43], v103 offset:1536
    ds_read_b64_tr_b16 v[156:157], v97 offset:32768
    ds_read_b64_tr_b16 v[158:159], v97 offset:36864
    ds_read_b64_tr_b16 v[160:161], v97 offset:40960
    ds_read_b64_tr_b16 v[162:163], v97 offset:45056
    s_waitcnt lgkmcnt(7)
    v_mfma_f32_16x16x32_bf16 v[60:63], v[140:143], v[28:31], 0
    v_add_f32 v12, v12, v72
    v_add_f32 v13, v13, v73
    v_add_f32 v14, v14, v74
    v_mfma_f32_16x16x32_bf16 v[64:67], v[144:147], v[28:31], 0
    v_add_f32 v15, v15, v75
    v_add_f32 v12, v12, v13
    v_add_f32 v14, v14, v15
    s_waitcnt lgkmcnt(6)
    v_mfma_f32_16x16x32_bf16 v[60:63], v[148:151], v[32:35], v[60:63]
    v_add_f32 v21, v12, v14
    s_nop 1
    v_add_f32_dpp v21, v21, v21 row_ror:4 row_mask:0xf bank_mask:0xf
    v_mfma_f32_16x16x32_bf16 v[64:67], v[152:155], v[32:35], v[64:67]
    s_nop 1
    v_add_f32_dpp v21, v21, v21 row_ror:8 row_mask:0xf bank_mask:0xf
    s_waitcnt lgkmcnt(2)
    v_mfma_f32_16x16x32_bf16 v[60:63], v[156:159], v[36:39], v[60:63]
    s_waitcnt lgkmcnt(0)
    v_mfma_f32_16x16x32_bf16 v[64:67], v[160:163], v[36:39], v[64:67]
    s_mov_b64 exec, 15
    s_cmp_lg_u32 s37, 0
    s_cbranch_scc1 L_sc1
    global_store_dwordx4 v108, v[20:23], s[26:27]
L_sd2:
    s_mov_b64 exec, -1
    global_load_dword v71, v114, s[26:27] offset:128 sc1
    s_waitcnt vmcnt(2)
    s_branch L_b6
L_pv:
    ds_read_b128 v[28:31], v103 offset:0
    ds_read_b128 v[32:35], v103 offset:512
    ds_read_b128 v[36:39], v103 offset:1024
    ds_read_b128 v[40:43], v103 offset:1536
    ds_read_b64_tr_b16 v[156:157], v97 offset:32768
    ds_read_b64_tr_b16 v[158:159], v97 offset:36864
    ds_read_b64_tr_b16 v[160:161], v97 offset:40960
    ds_read_b64_tr_b16 v[162:163], v97 offset:45056
    s_waitcnt lgkmcnt(7)
    v_mfma_f32_16x16x32_bf16 v[60:63], v[140:143], v[28:31], 0
    v_mfma_f32_16x16x32_bf16 v[64:67], v[144:147], v[28:31], 0
    s_waitcnt lgkmcnt(6)
    v_mfma_f32_16x16x32_bf16 v[60:63], v[148:151], v[32:35], v[60:63]
    v_mfma_f32_16x16x32_bf16 v[64:67], v[152:155], v[32:35], v[64:67]
    s_waitcnt lgkmcnt(2)
    v_mfma_f32_16x16x32_bf16 v[60:63], v[156:159], v[36:39], v[60:63]
    s_waitcnt lgkmcnt(0)
    v_mfma_f32_16x16x32_bf16 v[64:67], v[160:163], v[36:39], v[64:67]
    global_load_dword v71, v114, s[26:27] offset:128 sc1
    s_waitcnt vmcnt(1)
L_b6:
    s_barrier
    ds_read_b64_tr_b16 v[164:165], v97 offset:49152
    ds_read_b64_tr_b16 v[166:167], v97 offset:53248
    ds_read_b64_tr_b16 v[168:169], v97 offset:57344
    ds_read_b64_tr_b16 v[170:171], v97 offset:61440
    s_waitcnt lgkmcnt(2)
    v_mfma_f32_16x16x32_bf16 v[60:63], v[164:167], v[40:43], v[60:63]
    s_waitcnt lgkmcnt(0)
    v_mfma_f32_16x16x32_bf16 v[64:67], v[168:171], v[40:43], v[64:67]
    s_nop 7
    v_add_f32_dpp v60, v64, v60 row_ror:8 row_mask:0xf bank_mask:0xf
    v_add_f32_dpp v61, v65, v61 row_ror:8 row_mask:0xf bank_mask:0xf
    v_add_f32_dpp v62, v66, v62 row_ror:8 row_mask:0xf bank_mask:0xf
    v_add_f32_dpp v63, v67, v63 row_ror:8 row_mask:0xf bank_mask:0xf
    s_mov_b64 exec, s[42:43]
    s_cmp_lg_u32 s37, 0
    v_bfi_b32 v60, v4, v60, s32
    v_bfi_b32 v61, v4, v61, s33
    v_bfi_b32 v62, v4, v62, s34
    v_bfi_b32 v63, v4, v63, s35
    s_cbranch_scc1 L_sc3
    global_store_dwordx4 v107, v[60:63], s[26:27]
L_sd4:
    s_mov_b64 exec, -1
    s_cmp_ge_u32 s30, 28
    s_cbranch_scc1 L_exit_a
    s_waitcnt vmcnt(1)
    s_barrier
    v_cmp_ne_u32 vcc, s31, v71
    s_cbranch_vccnz L_fwait
L_fgo:
    s_lshl_b32 s44, s28, 11
    s_mov_b32 m0, s44
    s_add_u32 s45, s44, 16384
    global_load_lds_dwordx4 v116, s[16:17] offset:0 nt
    global_load_ushort v70, v123, s[4:5] sc1
    global_load_lds_dwordx4 v117, s[16:17] offset:1024 nt
    s_mov_b32 m0, s45
    s_nop 0
    global_load_lds_dwordx4 v116, s[18:19] offset:0 nt
    global_load_lds_dwordx4 v117, s[18:19] offset:1024 nt
    s_mov_b32 s46, 0x10000
    s_mov_b32 s47, 0
    s_mov_b32 s48, 0x1ffff
    s_mov_b32 s49, 0
    s_waitcnt vmcnt(0)
    s_barrier
    ds_read_b64_tr_b16 v[44:45], v118 offset:0
    ds_read_b64_tr_b16 v[52:53], v118 offset:16384
    ds_read_b64_tr_b16 v[46:47], v118 offset:512
    ds_read_b64_tr_b16 v[54:55], v118 offset:16896
    ds_read_b64_tr_b16 v[48:49], v118 offset:4096
    ds_read_b64_tr_b16 v[56:57], v118 offset:20480
    ds_read_b64_tr_b16 v[50:51], v118 offset:4608
    ds_read_b64_tr_b16 v[58:59], v118 offset:20992
    v_lshlrev_b32 v70, 16, v70
L_hg:
    global_load_dwordx2 v[32:33], v119, s[26:27] sc1
    s_mov_b64 exec, -1
    s_sub_u32 s38, s38, 1
    s_cbranch_scc1 L_end
L_hg_c:
    s_waitcnt vmcnt(0)
    v_xor_b32 v28, v124, v32
    v_xor_b32 v29, v125, v33
    v_or_b32 v30, v28, v29
    s_nop 0
    v_permlane32_swap_b32 v28, v29
    v_or_b32_dpp v30, v30, v30 quad_perm:[1,0,3,2] row_mask:0xf bank_mask:0xf
    v_cmp_ne_u32_sdwa vcc, v30, v5 src0_sel:BYTE_0 src1_sel:DWORD
    s_cbranch_vccz L_hg_ok
    s_mov_b64 exec, vcc
    s_branch L_hg
L_hg_ok:
    v_add_f32 v28, v28, v29
    v_mov_b32 v29, v28
    s_nop 1
    v_permlane16_swap_b32 v28, v29
    v_add_f32 v28, v28, v29
    s_nop 1
    v_add_f32_dpp v28, v28, v28 row_ror:8 row_mask:0xf bank_mask:0xf
    v_cvt_pk_bf16_f32 v28, v28, v28
    v_lshlrev_b32 v28, 16, v28
    v_add_f32 v28, v28, v70
    v_cvt_pk_bf16_f32 v28, v28, v28
    ds_write_b16 v120, v28
    v_mov_b32 v76, 0
    s_waitcnt lgkmcnt(0)
    s_barrier
    ds_read_u16_d16_hi v76, v126
    ds_read_b128 v[36:39], v121
    ds_read_b128 v[40:43], v121 offset:64
    s_waitcnt lgkmcnt(2)
    v_readfirstlane_b32 s44, v76
    s_waitcnt lgkmcnt(1)
    v_mfma_f32_16x16x32_bf16 v[60:63], v[36:39], v[44:47], 0
    v_mfma_f32_16x16x32_bf16 v[64:67], v[36:39], v[52:55], 0
    v_subrev_f32 v76, s44, v76
    v_mul_f32 v77, v76, v76
    s_waitcnt lgkmcnt(0)
    v_mfma_f32_16x16x32_bf16 v[60:63], v[40:43], v[48:51], v[60:63]
    v_mfma_f32_16x16x32_bf16 v[64:67], v[40:43], v[56:59], v[64:67]
    v_permlane32_swap_b32 v76, v77
    v_add_f32 v76, v76, v77
    v_mov_b32 v77, v76
    s_nop 1
    v_permlane16_swap_b32 v76, v77
    v_add_f32 v76, v76, v77
    v_bfi_b32 v28, v4, v60, s32
    s_nop 0
    v_add_f32_dpp v76, v76, v76 row_ror:8 row_mask:0xf bank_mask:0xf
    v_bfi_b32 v29, v4, v61, s33
    s_nop 0
    v_add_f32_dpp v76, v76, v76 row_ror:4 row_mask:0xf bank_mask:0xf
    v_bfi_b32 v30, v4, v64, s34
    s_nop 0
    v_add_f32_dpp v76, v76, v76 row_ror:2 row_mask:0xf bank_mask:0xf
    v_bfi_b32 v31, v4, v65, s35
    s_nop 0
    v_add_f32_dpp v76, v76, v76 row_ror:1 row_mask:0xf bank_mask:0xf
    s_mov_b64 exec, s[46:47]
    v_readlane_b32 s45, v76, 0
    v_readlane_b32 s50, v76, 32
    v_mov_b32 v28, s44
    v_mov_b32 v31, s31
    v_mov_b32 v29, s45
    v_mov_b32 v30, s50
    s_mov_b64 exec, s[48:49]
    s_cmp_lg_u32 s37, 0
    s_cbranch_scc1 L_sc5
    global_store_dwordx4 v122, v[28:31], s[26:27]
L_sd6:
    s_mov_b64 exec, -1
L_exit_a:
    s_endpgm
L_service:
    s_add_u32 s44, s28, s30
    s_cmp_lg_u32 s44, 22
    s_cbranch_scc1 L_notv
    s_lshl_b32 s44, s29, 24
    s_add_u32 s44, s44, 15728640
    v_mov_b32 v81, s44
    s_mov_b64 exec, 1
    global_load_dword v94, v81, s[8:9]
    s_mov_b64 exec, -1
L_notv:
    s_getreg_b32 s36, hwreg(HW_REG_XCC_ID, 0, 4)
    v_mov_b32 v4, 0xffffff00
    v_mov_b32 v5, 0
    s_mov_b32 s40, 0x00010001
    s_mov_b32 s41, 0x00010001
    s_mov_b32 s42, 0x000f000f
    s_mov_b32 s43, 0x000f000f
    s_mov_b32 s38, 1048576
    s_mov_b32 s37, 0
    v_bfe_u32 v18, v0, 2, 2
    v_and_b32 v9, 3, v0
    v_lshlrev_b32 v19, 3, v9
    v_lshl_add_u32 v8, v3, 3, v18
    v_lshlrev_b32 v24, 7, v8
    v_add_u32 v24, v24, v19
    v_lshrrev_b32 v25, 1, v18
    v_or_b32 v25, v25, v11
    v_lshl_or_b32 v24, v25, 5, v24
    v_and_b32 v27, 31, v0
    v_lshlrev_b32 v27, 2, v27
    v_add_u32 v27, 135808, v27
    ds_write_b32 v27, v5
    v_cmp_eq_u32 s[14:15], 0, v2
    v_cmp_eq_u32 s[24:25], 1, v2
    v_cmp_eq_u32 s[0:1], 2, v2
    v_cmp_eq_u32 s[46:47], 3, v2
    s_lshl_b32 s59, s29, 4
    s_add_u32 s59, s59, s30
    s_lshl_b32 s44, s29, 19
    s_lshl_b32 s45, s30, 15
    s_add_u32 s44, s44, s45
    s_lshl_b32 s45, s28, 7
    s_add_u32 s44, s44, s45
    v_lshl_add_u32 v96, v7, 10, v10
    v_add_u32 v96, s44, v96
    v_xor_b32 v97, 64, v96
    v_add_u32 v97, 7168, v97
    v_add_u32 v98, 14336, v96
    v_add_u32 v99, 14336, v97
    s_lshl_b32 s58, s28, 12
    s_add_u32 s58, s58, 65536
    s_lshl_b32 s44, s59, 11
    s_lshl_b32 s45, s28, 8
    s_add_u32 s44, s44, s45
    s_add_u32 s44, s44, 786432
    v_lshl_add_u32 v100, v1, 7, s44
    s_lshr_b32 s48, s59, 2
    s_and_b32 s39, s28, 1
    s_lshl_b32 s44, s48, 8
    s_lshl_b32 s45, s39, 7
    s_add_u32 s44, s44, s45
    s_add_u32 s44, s44, 8192
    v_writelane_b32 v100, s44, 2
    s_lshl_b32 s44, s48, 8
    s_add_u32 s44, s44, 8192
    v_lshl_add_u32 v111, v2, 4, s44
    v_mov_b32 v25, 135808
    v_lshlrev_b32 v26, 4, v3
    v_add_u32 v26, 135744, v26
    v_cndmask_b32 v102, v25, v26, s[14:15]
    v_cndmask_b32 v103, v25, v26, s[24:25]
    v_cndmask_b32 v104, v25, v26, s[0:1]
    v_cndmask_b32 v105, v25, v26, s[46:47]
    v_add_u32 v106, s58, v24
    v_xor_b32 v107, 32, v106
    v_xor_b32 v108, 64, v106
    v_xor_b32 v109, 0x60, v106
    s_lshl_b32 s44, s59, 11
    s_lshl_b32 s45, s28, 8
    s_add_u32 s44, s44, s45
    s_add_u32 s44, s44, 786432
    v_lshlrev_b32 v110, 6, v2
    v_lshl_add_u32 v110, v3, 4, v110
    v_add_u32 v110, s44, v110
    s_lshl_b32 s44, s29, 15
    s_lshl_b32 s45, s30, 7
    s_add_u32 s44, s44, s45
    s_add_u32 s44, s44, 786432
    v_and_b32 v27, 7, v0
    v_lshlrev_b32 v115, 11, v7
    v_lshl_add_u32 v115, v27, 4, v115
    v_add_u32 v115, s44, v115
    v_add_u32 v122, 0x4000, v115
    s_lshl_b32 s44, s59, 11
    s_add_u32 s44, s44, 786432
    v_add_u32 v112, s44, v16
    v_lshlrev_b32 v113, 2, v7
    v_and_b32 v27, 7, v0
    v_lshlrev_b32 v114, 3, v27
    v_lshl_add_u32 v114, v3, 1, v114
    v_add_u32 v114, 135744, v114
    s_lshl_b32 s44, s59, 7
    s_add_u32 s44, s44, 1310720
    v_lshlrev_b32 v116, 14, v7
    v_lshl_add_u32 v116, v27, 4, v116
    v_add_u32 v116, s44, v116
    s_lshl_b32 s44, s59, 3
    v_lshl_add_u32 v117, v3, 1, s44
    s_lshl_b32 s44, s59, 4
    s_lshl_b32 s45, s29, 14
    s_add_u32 s44, s44, s45
    s_add_u32 s44, s44, 1310720
    v_lshlrev_b32 v118, 11, v27
    v_lshl_add_u32 v118, v3, 2, v118
    v_add_u32 v118, s44, v118
    s_lshl_b32 s44, s59, 4
    s_add_u32 s44, s44, 524288
    v_lshl_add_u32 v120, v1, 11, s44
    v_add_u32 v121, 0x20000, v120
    s_lshr_b32 s48, s30, 2
    s_lshl_b32 s3, s48, 3
    s_and_b32 s48, s29, 1
    s_xor_b32 s48, s48, 1
    s_lshl_b32 s48, s48, 2
    s_lshr_b32 s45, s29, 1
    s_or_b32 s48, s48, s45
    s_add_u32 s3, s3, s48
    s_and_b32 s48, s30, 3
    s_lshl_b32 s39, s3, 2
    s_add_u32 s39, s39, s48
    v_lshl_add_u32 v8, v3, 2, v18
    s_lshl_b32 s44, s39, 14
    s_lshl_b32 s45, s28, 7
    s_add_u32 s44, s44, s45
    v_and_b32 v124, 7, v0
    v_lshlrev_b32 v25, 1, v3
    v_xor_b32 v124, v124, v25
    v_lshlrev_b32 v124, 4, v124
    v_lshl_add_u32 v124, v7, 10, v124
    v_add_u32 v124, s44, v124
    v_add_u32 v125, 7168, v124
    v_bfe_u32 v26, v8, 1, 2
    v_lshlrev_b32 v26, 5, v26
    v_lshl_add_u32 v25, v8, 7, v26
    v_add_u32 v25, v25, v19
    s_lshl_b32 s44, s28, 11
    s_add_u32 s44, s44, 32768
    v_add_u32 v126, s44, v25
    v_xor_b32 v127, 32, v126
    v_xor_b32 v128, 64, v126
    v_xor_b32 v129, 0x60, v126
    v_and_b32 v26, 7, v0
    s_lshl_b32 s44, s39, 11
    s_add_u32 s44, s44, 1048576
    v_lshlrev_b32 v130, 8, v18
    v_lshl_add_u32 v130, v3, 6, v130
    v_lshl_add_u32 v130, v9, 4, v130
    v_add_u32 v130, s44, v130
    s_lshl_b32 s44, s39, 11
    s_lshl_b32 s45, s28, 8
    s_add_u32 s44, s44, s45
    s_add_u32 s44, s44, 1048576
    v_lshl_add_u32 v139, v1, 7, s44
    s_lshl_b32 s44, s39, 7
    s_add_u32 s44, s44, 196608
    v_lshl_add_u32 v131, v26, 4, s44
    v_writelane_b32 v139, s44, 2
    v_lshl_add_u32 v132, v3, 2, v9
    v_lshlrev_b32 v132, 1, v132
    v_add_u32 v132, 135744, v132
    v_mov_b32 v25, 135808
    v_lshlrev_b32 v26, 3, v3
    v_add_u32 v26, 135744, v26
    v_cndmask_b32 v134, v25, v26, s[14:15]
    v_cndmask_b32 v135, v25, v26, s[24:25]
    v_cndmask_b32 v136, v25, v26, s[0:1]
    v_cndmask_b32 v137, v25, v26, s[46:47]
    s_lshl_b32 s44, s39, 11
    s_lshl_b32 s45, s28, 8
    s_add_u32 s44, s44, s45
    s_add_u32 s44, s44, 524288
    v_lshlrev_b32 v138, 6, v2
    v_lshl_add_u32 v138, v3, 4, v138
    v_add_u32 v138, s44, v138
    v_mov_b32 v25, 135808
    s_waitcnt vmcnt(1)
    global_load_lds_dwordx4 v14, s[10:11] offset:2048 nt
    s_cmp_lg_u32 s28, 0
    s_cbranch_scc1 L_noln
    s_waitcnt vmcnt(4)
    v_lshlrev_b32 v28, 16, v20
    v_and_b32 v29, 0xffff0000, v20
    v_lshlrev_b32 v30, 16, v21
    v_and_b32 v31, 0xffff0000, v21
    v_lshlrev_b32 v32, 16, v22
    v_and_b32 v33, 0xffff0000, v22
    v_lshlrev_b32 v34, 16, v23
    v_and_b32 v35, 0xffff0000, v23
    v_add_f32 v26, v28, v29
    v_add_f32 v27, v30, v31
    v_add_f32 v36, v32, v33
    v_add_f32 v37, v34, v35
    v_add_f32 v26, v26, v27
    v_add_f32 v36, v36, v37
    v_add_f32 v26, v26, v36
    s_nop 1
    v_add_f32_dpp v26, v26, v26 row_ror:8 row_mask:0xf bank_mask:0xf
    s_nop 1
    v_add_f32_dpp v26, v26, v26 row_ror:4 row_mask:0xf bank_mask:0xf
    s_nop 1
    v_add_f32_dpp v26, v26, v26 row_ror:2 row_mask:0xf bank_mask:0xf
    s_nop 1
    v_add_f32_dpp v26, v26, v26 row_ror:1 row_mask:0xf bank_mask:0xf
    v_mov_b32 v27, v26
    s_nop 1
    v_permlane32_swap_b32 v26, v27
    v_add_f32 v26, v26, v27
    v_mov_b32 v27, v26
    s_nop 1
    v_permlane16_swap_b32 v26, v27
    v_add_f32 v26, v26, v27
    v_mul_f32 v26, 0x3b000000, v26
    v_sub_f32 v36, v28, v26
    v_sub_f32 v37, v29, v26
    v_sub_f32 v38, v30, v26
    v_sub_f32 v39, v31, v26
    v_sub_f32 v40, v32, v26
    v_sub_f32 v41, v33, v26
    v_sub_f32 v42, v34, v26
    v_sub_f32 v43, v35, v26
    v_mul_f32 v27, v36, v36
    v_mul_f32 v44, v37, v37
    v_fmac_f32 v27, v38, v38
    v_fmac_f32 v44, v39, v39
    v_fmac_f32 v27, v40, v40
    v_fmac_f32 v44, v41, v41
    v_fmac_f32 v27, v42, v42
    v_fmac_f32 v44, v43, v43
    v_add_f32 v27, v27, v44
    s_nop 1
    v_add_f32_dpp v27, v27, v27 row_ror:8 row_mask:0xf bank_mask:0xf
    s_nop 1
    v_add_f32_dpp v27, v27, v27 row_ror:4 row_mask:0xf bank_mask:0xf
    s_nop 1
    v_add_f32_dpp v27, v27, v27 row_ror:2 row_mask:0xf bank_mask:0xf
    s_nop 1
    v_add_f32_dpp v27, v27, v27 row_ror:1 row_mask:0xf bank_mask:0xf
    v_mov_b32 v36, v27
    s_nop 1
    v_permlane32_swap_b32 v27, v36
    v_add_f32 v27, v27, v36
    v_mov_b32 v36, v27
    s_nop 1
    v_permlane16_swap_b32 v27, v36
    v_add_f32 v27, v27, v36
    v_mul_f32 v27, 0x3b000000, v27
    v_cvt_pk_bf16_f32 v26, v26, v27
    v_and_b32 v27, 0xffff0000, v26
    v_lshlrev_b32 v26, 16, v26
    v_add_f32 v27, 0x37280000, v27
    v_cvt_pk_bf16_f32 v27, v27, v27
    v_lshlrev_b32 v27, 16, v27
    v_sqrt_f32 v27, v27
    v_sub_f32 v28, v28, v26
    v_sub_f32 v29, v29, v26
    v_sub_f32 v30, v30, v26
    v_sub_f32 v31, v31, v26
    v_sub_f32 v32, v32, v26
    v_sub_f32 v33, v33, v26
    v_sub_f32 v34, v34, v26
    v_sub_f32 v35, v35, v26
    v_cvt_pk_bf16_f32 v27, v27, v27
    v_lshlrev_b32 v27, 16, v27
    v_rcp_f32 v27, v27
    v_cvt_pk_bf16_f32 v20, v28, v29
    v_cvt_pk_bf16_f32 v21, v30, v31
    v_cvt_pk_bf16_f32 v22, v32, v33
    v_cvt_pk_bf16_f32 v23, v34, v35
    v_lshlrev_b32 v28, 16, v20
    v_and_b32 v29, 0xffff0000, v20
    v_lshlrev_b32 v30, 16, v21
    v_and_b32 v31, 0xffff0000, v21
    v_lshlrev_b32 v32, 16, v22
    v_and_b32 v33, 0xffff0000, v22
    v_lshlrev_b32 v34, 16, v23
    v_and_b32 v35, 0xffff0000, v23
    v_mul_f32 v28, v28, v27
    v_mul_f32 v29, v29, v27
    v_mul_f32 v30, v30, v27
    v_mul_f32 v31, v31, v27
    v_mul_f32 v32, v32, v27
    v_mul_f32 v33, v33, v27
    v_mul_f32 v34, v34, v27
    v_mul_f32 v35, v35, v27
    v_cvt_pk_bf16_f32 v20, v28, v29
    v_cvt_pk_bf16_f32 v21, v30, v31
    v_cvt_pk_bf16_f32 v22, v32, v33
    v_cvt_pk_bf16_f32 v23, v34, v35
    v_add_u32 v26, 131072, v16
    ds_write_b128 v26, v[20:23]
L_noln:
    s_waitcnt vmcnt(1)
    global_load_lds_dwordx4 v15, s[10:11] offset:3072 nt
    s_lshl_b32 s44, s57, 9
    s_lshl_b32 s45, s28, 6
    s_add_u32 s44, s44, s45
    s_add_u32 s44, s44, 131072
    v_lshl_add_u32 v26, v3, 4, s44
    v_cndmask_b32 v12, v25, v26, s[14:15]
    v_cndmask_b32 v13, v25, v26, s[24:25]
    v_cndmask_b32 v14, v25, v26, s[0:1]
    v_cndmask_b32 v15, v25, v26, s[46:47]
    v_add_u32 v20, s49, v24
    v_xor_b32 v21, 32, v20
    v_xor_b32 v22, 64, v20
    v_xor_b32 v23, 0x60, v20
    s_waitcnt lgkmcnt(0)
    s_barrier
    ds_read_b128 v[28:31], v12
    ds_read_b128 v[32:35], v13
    ds_read_b128 v[36:39], v14
    ds_read_b128 v[40:43], v15
    s_add_u32 s31, s31, 2654435769
    s_and_b32 s32, s31, 0xff
    s_bfe_u32 s33, s31, 0x80008
    s_bfe_u32 s34, s31, 0x80010
    s_lshr_b32 s35, s31, 24
    v_lshlrev_b32 v12, 4, v2
    v_lshl_add_u32 v12, v3, 2, v12
    v_mul_u32_u24 v12, 36, v12
    s_lshl_b32 s44, s28, 2
    s_add_u32 s44, s44, 132096
    v_add_u32 v12, s44, v12
    v_mul_u32_u24 v13, 36, v1
    v_add_u32 v13, 132096, v13
    v_lshl_add_u32 v17, v1, 3, s54
    v_mov_b32 v66, s31
    v_mov_b32 v67, s36
    s_mov_b32 s52, 0x55555555
    s_mov_b32 s53, 0x55555555
    v_lshlrev_b32 v119, 3, v3
    v_lshrrev_b32 v119, v119, s31
    v_and_b32 v119, 0xff, v119
    s_waitcnt vmcnt(0)
    ds_read_b64_tr_b16 v[72:73], v20 offset:0
    ds_read_b64_tr_b16 v[74:75], v20 offset:512
    ds_read_b64_tr_b16 v[76:77], v21 offset:0
    ds_read_b64_tr_b16 v[78:79], v21 offset:512
    ds_read_b64_tr_b16 v[80:81], v22 offset:0
    ds_read_b64_tr_b16 v[82:83], v22 offset:512
    ds_read_b64_tr_b16 v[84:85], v23 offset:0
    ds_read_b64_tr_b16 v[86:87], v23 offset:512
    s_waitcnt lgkmcnt(6)
    v_mfma_f32_16x16x32_bf16 v[60:63], v[72:75], v[28:31], 0
    s_waitcnt lgkmcnt(4)
    v_mfma_f32_16x16x32_bf16 v[60:63], v[76:79], v[32:35], v[60:63]
    s_waitcnt lgkmcnt(2)
    v_mfma_f32_16x16x32_bf16 v[60:63], v[80:83], v[36:39], v[60:63]
    s_waitcnt lgkmcnt(0)
    v_mfma_f32_16x16x32_bf16 v[60:63], v[84:87], v[40:43], v[60:63]
    s_mov_b64 exec, s[42:43]
    s_nop 6
    ds_write2_b32 v12, v60, v61 offset0:0 offset1:9
    ds_write2_b32 v12, v62, v63 offset0:18 offset1:27
    s_mov_b64 exec, -1
    s_waitcnt lgkmcnt(0)
    s_barrier
    s_cmp_lg_u32 s28, 0
    s_cbranch_scc1 L_qsent
    ds_read2_b32 v[28:29], v13 offset0:0 offset1:1
    ds_read2_b32 v[30:31], v13 offset0:2 offset1:3
    ds_read2_b32 v[32:33], v13 offset0:4 offset1:5
    ds_read2_b32 v[34:35], v13 offset0:6 offset1:7
    s_waitcnt lgkmcnt(0)
    v_add_f32 v28, v28, v29
    v_add_f32 v30, v30, v31
    v_add_f32 v32, v32, v33
    v_add_f32 v34, v34, v35
    v_add_f32 v28, v28, v30
    v_add_f32 v32, v32, v34
    v_add_f32 v64, v28, v32
    s_nop 1
    v_mov_b32_dpp v65, v64 quad_perm:[1,1,3,3] row_mask:0xf bank_mask:0xf
    s_mov_b64 exec, s[52:53]
    global_store_dwordx4 v17, v[64:67], s[26:27]
    v_add_u32 v17, 65536, v17
    global_store_dwordx4 v17, v[64:67], s[26:27] sc1
    s_mov_b64 exec, 1
    s_lshl_b32 s44, s59, 4
    s_add_u32 s44, s44, 4096
    v_mov_b32 v27, s44
    v_mov_b32 v28, s36
    v_mov_b32 v29, s31
    global_store_dwordx2 v27, v[28:29], s[26:27] sc1
    s_mov_b64 exec, -1
    global_load_ushort v80, v117, s[4:5]
    s_mov_b64 exec, 1
    s_cmp_lg_u32 s30, 8
    s_cbranch_scc1 L_tl7
    global_load_dword v81, v96, s[12:13]
L_tl7:
    s_cmp_lg_u32 s30, 9
    s_cbranch_scc1 L_tl8
    v_mov_b32 v81, 0
    global_load_dword v81, v81, s[16:17]
L_tl8:
    s_cmp_lg_u32 s30, 10
    s_cbranch_scc1 L_tl9
    v_mov_b32 v81, 0
    global_load_dword v81, v81, s[18:19]
L_tl9:
    s_cmp_lg_u32 s30, 11
    s_cbranch_scc1 L_tl10
    v_mov_b32 v81, 0
    global_load_dword v81, v81, s[20:21]
L_tl10:
    s_cmp_lg_u32 s30, 12
    s_cbranch_scc1 L_tl11
    v_mov_b32 v81, 0
    global_load_dword v81, v81, s[22:23]
L_tl11:
    s_cmp_lg_u32 s30, 13
    s_cbranch_scc1 L_tl12
    v_mov_b32 v81, 1835004
    global_load_dword v81, v81, s[16:17]
L_tl12:
    s_cmp_lg_u32 s30, 14
    s_cbranch_scc1 L_tl13
    v_mov_b32 v81, 1835004
    global_load_dword v81, v81, s[18:19]
L_tl13:
    s_cmp_lg_u32 s30, 15
    s_cbranch_scc1 L_tl14
    v_mov_b32 v81, 1835004
    global_load_dword v81, v81, s[20:21]
L_tl14:
    s_mov_b64 exec, -1
L_qsent:
    s_barrier
    s_mov_b64 exec, 7
    global_load_dword v69, v100, s[26:27] sc1
    s_mov_b64 exec, -1
    s_mov_b64 exec, 1
    s_cmp_lg_u32 s28, 1
    s_cbranch_scc1 L_tw15
    global_load_ushort v81, v96, s[12:13]
L_tw15:
    s_cmp_lg_u32 s28, 2
    s_cbranch_scc1 L_tw16
    s_cmp_ge_u32 s3, 28
    s_cbranch_scc1 L_tw16
    global_load_ushort v81, v124, s[20:21]
L_tw16:
    s_cmp_lg_u32 s28, 3
    s_cbranch_scc1 L_tw17
    global_load_ushort v81, v5, s[22:23]
L_tw17:
    s_mov_b64 exec, -1
    s_cmp_lg_u32 s28, 0
    s_cbranch_scc1 L_qdone
    s_lshl_b32 s44, s29, 9
    s_add_u32 s44, s44, 16384
    v_lshl_add_u32 v27, v2, 2, s44
    s_mov_b32 s46, 64
L_wo_hold:
    global_load_dword v28, v27, s[26:27] sc1
    s_sub_u32 s46, s46, 1
    s_cbranch_scc1 L_qdone
    s_waitcnt vmcnt(0)
    v_cmp_ne_u32 vcc, s31, v28
    s_cbranch_vccnz L_wo_hold
L_qdone:
    s_lshl_b32 s44, s29, 9
    s_lshl_b32 s45, s30, 2
    s_add_u32 s44, s44, s45
    s_add_u32 s44, s44, 16384
    v_mov_b32 v90, s44
    v_mov_b32 v91, s31
    s_xor_b32 s8, s32, 90
    s_xor_b32 s9, s33, 90
    s_xor_b32 s10, s34, 90
    s_xor_b32 s11, s35, 90
    s_mov_b32 m0, s58
    s_barrier
    global_load_lds_dwordx4 v96, s[12:13] offset:0 nt
    global_load_lds_dwordx4 v97, s[12:13] offset:1024 nt
    global_load_lds_dwordx4 v98, s[12:13] offset:2048 nt
    global_load_lds_dwordx4 v99, s[12:13] offset:3072 nt
    s_barrier
    s_cmp_lg_u32 s28, 0
    s_cbranch_scc1 L_nowf
    s_mov_b64 exec, 1
    global_store_dword v90, v91, s[26:27] offset:128
    s_mov_b64 exec, -1
L_nowf:
    s_cmp_lg_u32 s28, 1
    s_cbranch_scc1 L_nohp
    s_not_b32 s44, s31
    v_lshrrev_b32 v40, 0, s44
    v_lshrrev_b32 v41, 8, s44
    v_lshrrev_b32 v42, 16, s44
    v_lshrrev_b32 v43, 24, s44
    global_store_dwordx4 v116, v[40:43], s[26:27] sc1
L_nohp:
    s_lshl_b32 s44, s29, 8
    s_add_u32 s44, s44, 4096
    v_lshl_add_u32 v27, v2, 4, s44
    s_cmp_lg_u32 s28, 6
    s_cbranch_scc1 L_wf
    global_load_dwordx2 v[34:35], v27, s[26:27] sc1
    s_waitcnt vmcnt(1)
L_ml:
    global_load_dwordx4 v[28:31], v111, s[26:27] sc1
    global_load_dwordx4 v[64:67], v112, s[26:27] offset:0 sc1
    global_load_dwordx4 v[68:71], v112, s[26:27] offset:1024 sc1
    s_waitcnt vmcnt(2)
    v_cmp_ne_u32 vcc, s31, v31
    v_mov_b32 v32, v28
    s_cbranch_vccnz L_ml_again
    global_load_dwordx4 v[140:143], v112, s[26:27] offset:0 sc1
    global_load_dwordx4 v[144:147], v112, s[26:27] offset:1024 sc1
    v_max_f32_dpp v32, v32, v32 row_ror:8 row_mask:0xf bank_mask:0xf
    s_nop 1
    v_max_f32_dpp v32, v32, v32 row_ror:4 row_mask:0xf bank_mask:0xf
    s_nop 1
    v_max_f32_dpp v32, v32, v32 row_ror:2 row_mask:0xf bank_mask:0xf
    s_nop 1
    v_max_f32_dpp v32, v32, v32 row_ror:1 row_mask:0xf bank_mask:0xf
    v_sub_f32 v28, v28, v32
    v_mul_f32 v28, 0x3fb8aa3b, v28
    v_exp_f32 v28, v28
    s_nop 0
    v_mul_f32 v32, v28, v29
    s_nop 1
    v_add_f32_dpp v32, v32, v32 row_ror:8 row_mask:0xf bank_mask:0xf
    s_nop 1
    v_add_f32_dpp v32, v32, v32 row_ror:4 row_mask:0xf bank_mask:0xf
    s_nop 1
    v_add_f32_dpp v32, v32, v32 row_ror:2 row_mask:0xf bank_mask:0xf
    s_nop 1
    v_add_f32_dpp v32, v32, v32 row_ror:1 row_mask:0xf bank_mask:0xf
    v_rcp_f32 v32, v32
    s_nop 0
    v_mul_f32 v28, v28, v32
    ds_bpermute_b32 v32, v113, v28 offset:0
    ds_bpermute_b32 v33, v113, v28 offset:32
    ds_read_b64_tr_b16 v[44:45], v106 offset:0
    ds_read_b64_tr_b16 v[46:47], v106 offset:512
    ds_read_b64_tr_b16 v[48:49], v107 offset:0
    ds_read_b64_tr_b16 v[50:51], v107 offset:512
    ds_read_b64_tr_b16 v[52:53], v108 offset:0
    ds_read_b64_tr_b16 v[54:55], v108 offset:512
    ds_read_b64_tr_b16 v[56:57], v109 offset:0
    ds_read_b64_tr_b16 v[58:59], v109 offset:512
    s_waitcnt lgkmcnt(8)
    s_branch L_og_w
L_og:
    global_load_dwordx4 v[140:143], v112, s[26:27] offset:0 sc1
    global_load_dwordx4 v[144:147], v112, s[26:27] offset:1024 sc1
L_og_w:
    s_waitcnt vmcnt(2)
    v_xor_b32 v64, s32, v64
    v_xor_b32 v65, s33, v65
    v_xor_b32 v66, s34, v66
    v_xor_b32 v67, s35, v67
    v_xor_b32 v68, s32, v68
    v_xor_b32 v69, s33, v69
    v_xor_b32 v70, s34, v70
    v_xor_b32 v71, s35, v71
    v_or3_b32 v36, v64, v65, v66
    v_or3_b32 v36, v36, v67, v68
    v_or3_b32 v36, v36, v69, v70
    v_or_b32 v36, v36, v71
    v_cmp_ne_u32_sdwa vcc, v36, v5 src0_sel:BYTE_0 src1_sel:DWORD
    v_mul_f32 v28, v32, v64
    v_mul_f32 v29, v32, v65
    v_mul_f32 v30, v32, v66
    v_mul_f32 v31, v32, v67
    v_fmac_f32 v28, v33, v68
    v_fmac_f32 v29, v33, v69
    v_fmac_f32 v30, v33, v70
    v_fmac_f32 v31, v33, v71
    s_cbranch_vccz L_og_ok
    global_load_dwordx4 v[64:67], v112, s[26:27] offset:0 sc1
    global_load_dwordx4 v[68:71], v112, s[26:27] offset:1024 sc1
    s_sub_u32 s38, s38, 1
    s_cbranch_scc1 L_end
    s_waitcnt vmcnt(2)
    v_xor_b32 v140, s32, v140
    v_xor_b32 v141, s33, v141
    v_xor_b32 v142, s34, v142
    v_xor_b32 v143, s35, v143
    v_xor_b32 v144, s32, v144
    v_xor_b32 v145, s33, v145
    v_xor_b32 v146, s34, v146
    v_xor_b32 v147, s35, v147
    v_or3_b32 v36, v140, v141, v142
    v_or3_b32 v36, v36, v143, v144
    v_or3_b32 v36, v36, v145, v146
    v_or_b32 v36, v36, v147
    v_cmp_ne_u32_sdwa vcc, v36, v5 src0_sel:BYTE_0 src1_sel:DWORD
    v_mul_f32 v28, v32, v140
    v_mul_f32 v29, v32, v141
    v_mul_f32 v30, v32, v142
    v_mul_f32 v31, v32, v143
    v_fmac_f32 v28, v33, v144
    v_fmac_f32 v29, v33, v145
    v_fmac_f32 v30, v33, v146
    v_fmac_f32 v31, v33, v147
    s_cbranch_vccnz L_og
L_og_ok:
    v_permlane32_swap_b32 v28, v30
    v_permlane32_swap_b32 v29, v31
    v_add_f32 v28, v28, v30
    v_add_f32 v29, v29, v31
    s_nop 1
    v_permlane16_swap_b32 v28, v29
    v_add_f32 v28, v28, v29
    s_nop 1
    v_add_f32_dpp v28, v28, v28 row_ror:8 row_mask:0xf bank_mask:0xf
    v_cvt_pk_bf16_f32 v28, v28, v28
    ds_write_b16 v114, v28
    s_branch L_px19_c
L_px19:
    global_load_dwordx2 v[34:35], v27, s[26:27] sc1
    s_sub_u32 s38, s38, 1
    s_cbranch_scc1 L_end
    s_waitcnt vmcnt(0)
L_px19_c:
    v_cmp_ne_u32 vcc, s31, v35
    s_cbranch_vccnz L_px19
    v_cmp_ne_u32 vcc, s36, v34
    s_cmp_lg_u64 vcc, 0
    s_cselect_b32 s37, 1, 0
    s_waitcnt lgkmcnt(0)
L_b7:
    s_barrier
    ds_read_b128 v[28:31], v102
    ds_read_b128 v[32:35], v103
    ds_read_b128 v[36:39], v104
    ds_read_b128 v[40:43], v105
    s_waitcnt lgkmcnt(3)
    v_mfma_f32_16x16x32_bf16 v[60:63], v[44:47], v[28:31], 0
    s_waitcnt lgkmcnt(2)
    v_mfma_f32_16x16x32_bf16 v[60:63], v[48:51], v[32:35], v[60:63]
    s_waitcnt lgkmcnt(1)
    v_mfma_f32_16x16x32_bf16 v[60:63], v[52:55], v[36:39], v[60:63]
    s_waitcnt lgkmcnt(0)
    v_mfma_f32_16x16x32_bf16 v[60:63], v[56:59], v[40:43], v[60:63]
    s_mov_b64 exec, s[42:43]
    s_cmp_lg_u32 s37, 0
    s_nop 5
    v_bfi_b32 v60, v4, v60, s8
    v_bfi_b32 v61, v4, v61, s9
    v_bfi_b32 v62, v4, v62, s10
    v_bfi_b32 v63, v4, v63, s11
    s_cbranch_scc1 L_sc20
    global_store_dwordx4 v110, v[60:63], s[26:27]
L_sd21:
    s_mov_b64 exec, -1
    s_cmp_lg_u32 s28, 0
    s_cbranch_scc1 L_hsent
    global_load_dwordx4 v[152:155], v115, s[26:27] sc1
    global_load_dwordx4 v[156:159], v122, s[26:27] sc1
L_pp:
    global_load_dwordx4 v[160:163], v115, s[26:27] sc1
    global_load_dwordx4 v[164:167], v122, s[26:27] sc1
L_pp_w:
    s_waitcnt vmcnt(2)
    v_xor_b32 v152, s8, v152
    v_xor_b32 v153, s9, v153
    v_xor_b32 v154, s10, v154
    v_xor_b32 v155, s11, v155
    v_xor_b32 v156, s8, v156
    v_xor_b32 v157, s9, v157
    v_xor_b32 v158, s10, v158
    v_xor_b32 v159, s11, v159
    v_or3_b32 v36, v152, v153, v154
    v_or3_b32 v36, v36, v155, v156
    v_or3_b32 v36, v36, v157, v158
    v_or_b32 v36, v36, v159
    v_cmp_ne_u32_sdwa vcc, v36, v5 src0_sel:BYTE_0 src1_sel:DWORD
    v_add_f32 v28, v152, v156
    v_add_f32 v29, v153, v157
    v_add_f32 v30, v154, v158
    v_add_f32 v31, v155, v159
    s_cbranch_vccz L_pp_ok
    global_load_dwordx4 v[152:155], v115, s[26:27] sc1
    global_load_dwordx4 v[156:159], v122, s[26:27] sc1
    s_sub_u32 s38, s38, 1
    s_cbranch_scc1 L_end
    s_waitcnt vmcnt(2)
    v_xor_b32 v160, s8, v160
    v_xor_b32 v161, s9, v161
    v_xor_b32 v162, s10, v162
    v_xor_b32 v163, s11, v163
    v_xor_b32 v164, s8, v164
    v_xor_b32 v165, s9, v165
    v_xor_b32 v166, s10, v166
    v_xor_b32 v167, s11, v167
    v_or3_b32 v36, v160, v161, v162
    v_or3_b32 v36, v36, v163, v164
    v_or3_b32 v36, v36, v165, v166
    v_or_b32 v36, v36, v167
    v_cmp_ne_u32_sdwa vcc, v36, v5 src0_sel:BYTE_0 src1_sel:DWORD
    v_add_f32 v28, v160, v164
    v_add_f32 v29, v161, v165
    v_add_f32 v30, v162, v166
    v_add_f32 v31, v163, v167
    s_cbranch_vccnz L_pp
L_pp_ok:
    v_permlane32_swap_b32 v28, v30
    v_permlane32_swap_b32 v29, v31
    v_add_f32 v28, v28, v30
    v_add_f32 v29, v29, v31
    s_nop 1
    v_permlane16_swap_b32 v28, v29
    v_add_f32 v28, v28, v29
    s_nop 1
    v_add_f32_dpp v28, v28, v28 row_ror:8 row_mask:0xf bank_mask:0xf
    v_mov_b32 v29, v28
    s_nop 1
    v_permlane16_swap_b32 v28, v29
    v_mov_b32 v30, v28
    v_mov_b32 v31, v29
    s_nop 0
    v_permlane32_swap_b32 v28, v30
    v_permlane32_swap_b32 v29, v31
    v_bfi_b32 v28, v4, v28, s32
    v_bfi_b32 v29, v4, v29, s33
    v_bfi_b32 v30, v4, v30, s34
    v_bfi_b32 v31, v4, v31, s35
    global_store_dwordx4 v116, v[28:31], s[26:27] sc1
L_hsent:
    s_lshl_b32 s44, s28, 11
    s_add_u32 s44, s44, 32768
    s_mov_b32 m0, s44
    s_barrier
    s_cmp_ge_u32 s3, 28
    s_cbranch_scc1 L_nodown
    s_mov_b64 exec, 7
    global_load_dword v71, v139, s[26:27] sc1
    s_mov_b64 exec, -1
    global_load_lds_dwordx4 v124, s[20:21] offset:0 nt
    global_load_lds_dwordx4 v125, s[20:21] offset:1024 nt
    s_not_b32 s44, s31
    v_lshrrev_b32 v40, 0, s44
    v_lshrrev_b32 v41, 8, s44
    v_lshrrev_b32 v42, 16, s44
    v_lshrrev_b32 v43, 24, s44
    s_mov_b64 exec, s[42:43]
    global_store_dwordx4 v138, v[40:43], s[26:27] sc1
    s_mov_b64 exec, -1
    s_waitcnt vmcnt(0)
    ds_read_b64_tr_b16 v[82:83], v126
    ds_read_b64_tr_b16 v[84:85], v127
    ds_read_b64_tr_b16 v[86:87], v128
    ds_read_b64_tr_b16 v[88:89], v129
    s_cmp_lg_u32 s28, 0
    s_cbranch_scc1 L_ba
    v_mov_b32 v40, 0xff
    v_mov_b32 v41, 0x42800000
    global_load_dwordx4 v[168:171], v131, s[26:27] sc1
    global_load_dwordx4 v[172:175], v130, s[26:27] offset:0 sc1
    global_load_dwordx4 v[176:179], v130, s[26:27] offset:1024 sc1
L_ug:
    global_load_dwordx4 v[180:183], v131, s[26:27] sc1
    global_load_dwordx4 v[184:187], v130, s[26:27] offset:0 sc1
    global_load_dwordx4 v[188:191], v130, s[26:27] offset:1024 sc1
L_ug_w:
    s_waitcnt vmcnt(3)
    v_readfirstlane_b32 s44, v168
    v_xor_b32 v38, s31, v171
    v_xor_b32 v172, s32, v172
    v_xor_b32 v173, s33, v173
    v_xor_b32 v174, s34, v174
    v_xor_b32 v175, s35, v175
    v_xor_b32 v176, s32, v176
    v_xor_b32 v177, s33, v177
    v_xor_b32 v178, s34, v178
    v_xor_b32 v179, s35, v179
    v_or3_b32 v39, v172, v173, v174
    v_or3_b32 v39, v39, v175, v176
    v_or3_b32 v39, v39, v177, v178
    v_or_b32 v39, v39, v179
    v_subrev_f32 v36, s44, v168
    v_and_or_b32 v38, v39, v40, v38
    v_cmp_ne_u32 vcc, 0, v38
    v_add_f32 v37, v169, v169
    v_fmac_f32 v37, v41, v36
    v_fma_f32 v37, v37, v36, v170
    v_fma_f32 v36, v41, v36, v169
    v_add_f32 v28, v172, v176
    v_add_f32 v29, v173, v177
    v_add_f32 v30, v174, v178
    v_add_f32 v31, v175, v179
    s_cbranch_vccz L_ug_ok
    global_load_dwordx4 v[168:171], v131, s[26:27] sc1
    global_load_dwordx4 v[172:175], v130, s[26:27] offset:0 sc1
    global_load_dwordx4 v[176:179], v130, s[26:27] offset:1024 sc1
    s_sub_u32 s38, s38, 1
    s_cbranch_scc1 L_end
    s_waitcnt vmcnt(3)
    v_readfirstlane_b32 s44, v180
    v_xor_b32 v38, s31, v183
    v_xor_b32 v184, s32, v184
    v_xor_b32 v185, s33, v185
    v_xor_b32 v186, s34, v186
    v_xor_b32 v187, s35, v187
    v_xor_b32 v188, s32, v188
    v_xor_b32 v189, s33, v189
    v_xor_b32 v190, s34, v190
    v_xor_b32 v191, s35, v191
    v_or3_b32 v39, v184, v185, v186
    v_or3_b32 v39, v39, v187, v188
    v_or3_b32 v39, v39, v189, v190
    v_or_b32 v39, v39, v191
    v_subrev_f32 v36, s44, v180
    v_and_or_b32 v38, v39, v40, v38
    v_cmp_ne_u32 vcc, 0, v38
    v_add_f32 v37, v181, v181
    v_fmac_f32 v37, v41, v36
    v_fma_f32 v37, v37, v36, v182
    v_fma_f32 v36, v41, v36, v181
    v_add_f32 v28, v184, v188
    v_add_f32 v29, v185, v189
    v_add_f32 v30, v186, v190
    v_add_f32 v31, v187, v191
    s_cbranch_vccnz L_ug
L_ug_ok:
    v_add_f32_dpp v36, v36, v36 quad_perm:[1,0,3,2] row_mask:0xf bank_mask:0xf
    v_add_f32_dpp v37, v37, v37 quad_perm:[1,0,3,2] row_mask:0xf bank_mask:0xf
    v_add_f32_dpp v28, v28, v28 row_ror:4 row_mask:0xf bank_mask:0xf
    v_add_f32_dpp v29, v29, v29 row_ror:4 row_mask:0xf bank_mask:0xf
    v_add_f32_dpp v30, v30, v30 row_ror:4 row_mask:0xf bank_mask:0xf
    v_add_f32_dpp v31, v31, v31 row_ror:4 row_mask:0xf bank_mask:0xf
    v_add_f32_dpp v36, v36, v36 quad_perm:[2,3,0,1] row_mask:0xf bank_mask:0xf
    v_add_f32_dpp v37, v37, v37 quad_perm:[2,3,0,1] row_mask:0xf bank_mask:0xf
    v_add_f32_dpp v28, v28, v28 row_ror:8 row_mask:0xf bank_mask:0xf
    v_add_f32_dpp v29, v29, v29 row_ror:8 row_mask:0xf bank_mask:0xf
    v_add_f32_dpp v30, v30, v30 row_ror:8 row_mask:0xf bank_mask:0xf
    v_add_f32_dpp v31, v31, v31 row_ror:8 row_mask:0xf bank_mask:0xf
    v_add_f32_dpp v36, v36, v36 row_half_mirror row_mask:0xf bank_mask:0xf
    v_add_f32_dpp v37, v37, v37 row_half_mirror row_mask:0xf bank_mask:0xf
    v_mul_f32 v38, 0x3b000000, v36
    v_mul_f32 v36, 0x3b000000, v37
    v_mov_b32 v37, v38
    v_fma_f32 v36, -v37, v37, v36
    v_add_f32 v37, s44, v37
    v_max_f32 v36, 0, v36
    v_cvt_pk_bf16_f32 v36, v37, v36
    v_and_b32 v37, 0xffff0000, v36
    v_lshlrev_b32 v36, 16, v36
    v_add_f32 v37, 0x37280000, v37
    v_cvt_pk_bf16_f32 v37, v37, v37
    v_lshlrev_b32 v37, 16, v37
    v_sqrt_f32 v37, v37
    s_nop 0
    v_cvt_pk_bf16_f32 v37, v37, v37
    v_lshlrev_b32 v37, 16, v37
    v_rcp_f32 v37, v37
    v_fma_f32 v28, -v36, v29, v28
    v_fma_f32 v30, -v36, v31, v30
    v_mul_f32 v28, v28, v37
    v_mul_f32 v30, v30, v37
    v_cvt_pk_bf16_f32 v28, v28, v30
    v_and_b32 v30, 0xffff0000, v28
    v_lshlrev_b32 v28, 16, v28
    v_mul_f32 v29, 0xbfb8aa3b, v28
    v_exp_f32 v29, v29
    s_nop 0
    v_add_f32 v29, 1.0, v29
    v_rcp_f32 v29, v29
    s_nop 0
    v_mul_f32 v28, v28, v29
    v_cvt_pk_bf16_f32 v28, v28, v28
    v_lshlrev_b32 v28, 16, v28
    v_mul_f32 v28, v28, v30
    v_cvt_pk_bf16_f32 v28, v28, v28
    ds_write_b16 v132, v28
    s_waitcnt lgkmcnt(0)
L_ba:
    s_barrier
    ds_read_b64 v[28:29], v134
    ds_read_b64 v[30:31], v135
    ds_read_b64 v[32:33], v136
    ds_read_b64 v[34:35], v137
    s_waitcnt lgkmcnt(2)
    v_mfma_f32_16x16x32_bf16 v[60:63], v[82:85], v[28:31], 0
    s_waitcnt lgkmcnt(0)
    v_mfma_f32_16x16x32_bf16 v[60:63], v[86:89], v[32:35], v[60:63]
    s_mov_b64 exec, s[42:43]
    s_nop 6
    v_bfi_b32 v60, v4, v60, s32
    v_bfi_b32 v61, v4, v61, s33
    v_bfi_b32 v62, v4, v62, s34
    v_bfi_b32 v63, v4, v63, s35
    global_store_dwordx4 v138, v[60:63], s[26:27] sc1
    s_mov_b64 exec, -1
    s_cmp_lg_u32 s28, 0
    s_cbranch_scc1 L_epoch
    s_mov_b64 exec, 1
    global_store_dword v90, v91, s[26:27] offset:256
L_final:
    s_mov_b64 exec, -1
    v_mov_b32 v32, s32
    v_mov_b32 v33, s33
    v_mov_b32 v34, s34
    v_mov_b32 v35, s35
    s_mov_b32 s46, -1
    s_mov_b32 s47, 0xffff
    s_mov_b64 s[48:49], -1
    s_mov_b64 s[50:51], s[46:47]
L_hp:
    global_load_dword v44, v118, s[26:27] sc1
    s_sub_u32 s38, s38, 1
    s_cbranch_scc1 L_end
    s_waitcnt vmcnt(0)
    v_xor_b32 v44, v119, v44
    v_cmp_ne_u32_sdwa vcc, v44, v5 src0_sel:BYTE_0 src1_sel:DWORD
    s_cbranch_vccnz L_hp
    global_load_dwordx4 v[28:31], v120, s[26:27] sc1
    s_mov_b64 exec, s[46:47]
    global_load_dwordx4 v[32:35], v121, s[26:27] sc1
    s_mov_b64 exec, -1
    v_add_f32_dpp v44, v44, v44 quad_perm:[1,0,3,2] row_mask:0xf bank_mask:0xf
    s_nop 1
    v_add_f32_dpp v44, v44, v44 quad_perm:[2,3,0,1] row_mask:0xf bank_mask:0xf
    s_nop 1
    v_add_f32_dpp v44, v44, v44 row_half_mirror row_mask:0xf bank_mask:0xf
    v_cvt_pk_bf16_f32 v44, v44, v44
    v_lshlrev_b32 v44, 16, v44
    v_lshlrev_b32 v22, 16, v80
    v_add_f32 v44, v44, v22
    v_cvt_pk_bf16_f32 v44, v44, v44
    v_lshlrev_b32 v22, 16, v44
    s_branch L_fc
L_fp:
    s_mov_b64 exec, s[48:49]
    s_cbranch_execz L_fa22
    global_load_dwordx4 v[28:31], v120, s[26:27] sc1
L_fa22:
    s_mov_b64 exec, s[50:51]
    s_cbranch_execz L_fb23
    global_load_dwordx4 v[32:35], v121, s[26:27] sc1
L_fb23:
    s_mov_b64 exec, -1
    s_sub_u32 s38, s38, 1
    s_cbranch_scc1 L_end
L_fc:
    s_waitcnt vmcnt(0)
    v_xor_b32 v36, s32, v28
    v_xor_b32 v37, s33, v29
    v_xor_b32 v38, s34, v30
    v_xor_b32 v39, s35, v31
    v_xor_b32 v40, s32, v32
    v_xor_b32 v41, s33, v33
    v_xor_b32 v42, s34, v34
    v_xor_b32 v43, s35, v35
    v_or3_b32 v44, v36, v37, v38
    v_or_b32 v44, v44, v39
    v_or3_b32 v45, v40, v41, v42
    v_or_b32 v45, v45, v43
    v_cmp_ne_u32_sdwa s[52:53], v44, v5 src0_sel:BYTE_0 src1_sel:DWORD
    v_cmp_ne_u32_sdwa s[54:55], v45, v5 src0_sel:BYTE_0 src1_sel:DWORD
    v_add_f32 v36, v36, v40
    v_add_f32 v37, v37, v41
    v_add_f32 v38, v38, v42
    v_add_f32 v39, v39, v43
    s_mov_b64 s[48:49], s[52:53]
    s_mov_b64 s[50:51], s[54:55]
    s_or_b64 s[52:53], s[52:53], s[54:55]
    s_cbranch_scc1 L_fp
    v_permlane32_swap_b32 v36, v38
    v_permlane32_swap_b32 v37, v39
    v_add_f32 v36, v36, v38
    v_add_f32 v37, v37, v39
    s_nop 1
    v_permlane16_swap_b32 v36, v37
    v_add_f32 v36, v36, v37
    s_nop 1
    v_add_f32_dpp v36, v36, v36 row_ror:8 row_mask:0xf bank_mask:0xf
    s_nop 1
    v_add_f32_dpp v36, v36, v36 row_ror:4 row_mask:0xf bank_mask:0xf
    s_nop 1
    v_add_f32_dpp v36, v36, v36 row_ror:2 row_mask:0xf bank_mask:0xf
    s_nop 1
    v_add_f32_dpp v36, v36, v36 row_ror:1 row_mask:0xf bank_mask:0xf
    v_cvt_pk_bf16_f32 v36, v36, v36
    v_lshlrev_b32 v36, 16, v36
    v_add_f32 v36, v36, v22
    v_cvt_pk_bf16_f32 v36, v36, v36
    s_mov_b64 exec, s[40:41]
    global_store_short v117, v36, s[22:23]
L_fin:
L_exit_s:
    s_endpgm
L_q_late:
L_pq:
    global_load_dwordx4 v[128:131], v110, s[26:27] sc1
    s_sub_u32 s38, s38, 1
    s_cbranch_scc1 L_end
    s_waitcnt vmcnt(0)
    v_cmp_ne_u32 vcc, s31, v130
    s_cbranch_vccz L_qok
    v_xor_b32 v110, 196608, v110
    s_branch L_pq
L_sc1:
    global_store_dwordx4 v108, v[20:23], s[26:27] sc1
    s_branch L_sd2
L_sc3:
    global_store_dwordx4 v107, v[60:63], s[26:27] sc1
    s_branch L_sd4
L_fwait:
    s_mov_b32 s46, 64
L_fhold:
    global_load_dword v71, v114, s[26:27] offset:128 sc1
    s_sub_u32 s46, s46, 1
    s_cbranch_scc1 L_fgo
    s_waitcnt vmcnt(0)
    v_cmp_ne_u32 vcc, s31, v71
    s_cbranch_vccnz L_fhold
    s_branch L_fgo
L_sc5:
    global_store_dwordx4 v122, v[28:31], s[26:27] sc1
    s_branch L_sd6
L_ml_again:
    s_sub_u32 s38, s38, 1
    s_cbranch_scc1 L_end
    s_waitcnt vmcnt(0)
    s_branch L_ml
L_wf:
L_px18:
    global_load_dwordx2 v[34:35], v27, s[26:27] sc1
    s_sub_u32 s38, s38, 1
    s_cbranch_scc1 L_end
    s_waitcnt vmcnt(0)
L_px18_c:
    v_cmp_ne_u32 vcc, s31, v35
    s_cbranch_vccnz L_px18
    v_cmp_ne_u32 vcc, s36, v34
    s_cmp_lg_u64 vcc, 0
    s_cselect_b32 s37, 1, 0
    ds_read_b64_tr_b16 v[44:45], v106 offset:0
    ds_read_b64_tr_b16 v[46:47], v106 offset:512
    ds_read_b64_tr_b16 v[48:49], v107 offset:0
    ds_read_b64_tr_b16 v[50:51], v107 offset:512
    ds_read_b64_tr_b16 v[52:53], v108 offset:0
    ds_read_b64_tr_b16 v[54:55], v108 offset:512
    ds_read_b64_tr_b16 v[56:57], v109 offset:0
    ds_read_b64_tr_b16 v[58:59], v109 offset:512
    s_branch L_b7
L_sc20:
    global_store_dwordx4 v110, v[60:63], s[26:27] sc1
    s_branch L_sd21
L_nodown:
    s_cmp_lg_u32 s28, 0
    s_cbranch_scc1 L_exit_s
    s_mov_b32 s46, 64
L_nd_hold:
    global_load_dword v47, v90, s[26:27] offset:240 sc1
    s_sub_u32 s46, s46, 1
    s_cbranch_scc1 L_final
    s_waitcnt vmcnt(0)
    v_cmp_ne_u32 vcc, s31, v47
    s_cbranch_vccnz L_nd_hold
    s_branch L_final
L_epoch:
    s_lshl_b32 s44, s59, 3
    s_add_u32 s44, s44, s28
    s_cmp_lg_u32 s44, 1
    s_cbranch_scc1 L_exit_s
    s_mov_b64 exec, 1
    global_store_dword v5, v91, s[26:27] sc1
    s_branch L_exit_s
L_end:
    s_endpgm
L_code_end:
.section .rodata,"a"
.p2align 6
.amdhsa_kernel sequential_preLN__sliding_block_cached__swiglu_ffn__decode_kernel
.amdhsa_next_free_vgpr 208
.amdhsa_next_free_sgpr 102
.amdhsa_accum_offset 208
.amdhsa_group_segment_fixed_size 0
.amdhsa_kernarg_size 96
.amdhsa_user_sgpr_count 2
.amdhsa_user_sgpr_kernarg_segment_ptr 1
.amdhsa_system_sgpr_workgroup_id_x 1
.amdhsa_float_denorm_mode_32 3
.end_amdhsa_kernel
```
